```python
import torch

def _softmax(x, axis=-1):
    return torch.softmax(x, dim=axis)
def _gelu(x):
    return torch.nn.functional.gelu(x, approximate="tanh")
def _silu(x):
    return torch.nn.functional.silu(x)
def _sigmoid(x):
    return torch.sigmoid(x)
def _layernorm(x, axis=-1, eps=1e-5):
    m = x.mean(dim=axis, keepdim=True)
    v = x.var(dim=axis, keepdim=True, unbiased=False)
    return (x - m) / torch.sqrt(v + eps)
def _scatter_add(tgt, idx, src, axis=0):
    return tgt.clone().index_add_(axis, idx, src)
def _segment_sum(src, seg, n):
    out = torch.zeros((n,) + src.shape[1:], dtype=src.dtype)
    return out.index_add_(0, seg, src)
def _pad(x, pw):
    flat = tuple(v for pair in reversed(pw) for v in pair)
    return torch.nn.functional.pad(x, flat)

kernel_name = 'standalone__paged_block_table_kv_pagedattention__decode'

def setup_inputs():

    _w = (lambda a: (lambda t: t.to(torch.bfloat16) if t.is_floating_point() else t)(torch.as_tensor(a)))
    B, Hq, Hkv, Sq, Skv, D = 1, 32, 32, 1, 4096, 128
    bs = 16
    nbps = max(1, Skv // bs)
    num_phys = B * nbps + 4
    bt = torch.randperm(num_phys)[: B * nbps].reshape(B, nbps).to(torch.int64)
    cl = (nbps * bs - (torch.arange(1, B + 1, dtype=torch.int64) * 2654435761) % max(1, nbps * bs // 2)).to(torch.int64)
    return {
        "q": _w((lambda *s: torch.randn(*s, dtype=torch.bfloat16) * 0.8)(B, Hq, Sq, D)),
        "k_cache": _w((lambda *s: torch.randn(*s, dtype=torch.bfloat16) * 0.8)(num_phys, bs, Hkv, D)),
        "v_cache": _w((lambda *s: torch.randn(*s, dtype=torch.bfloat16) * 0.05)(num_phys, bs, Hkv, D)),
        "block_table": _w(bt),
        "context_lens": _w(cl),
    }

def reference(q, k_cache, v_cache, block_table, context_lens):
    B, Hq, Sq, D = q.shape
    bs = k_cache.shape[1]
    Hkv = k_cache.shape[2]
    nbps = block_table.shape[1]
    Skv = nbps * bs
    bt = block_table.reshape(-1)
    k = (lambda x, *d: x.permute(*d))(k_cache[bt].reshape(B, Skv, Hkv, D), 0, 2, 1, 3)
    v = (lambda x, *d: x.permute(*d))(v_cache[bt].reshape(B, Skv, Hkv, D), 0, 2, 1, 3)
    g = Hq // Hkv
    qg = q.reshape(B, Hkv, g, Sq, D)
    scores = torch.einsum("bhgqd,bhkd->bhgqk", qg, k) * (D ** -0.5)
    pos = torch.arange(Skv)
    msk = pos[None, :] < context_lens[:, None]
    scores = torch.where(msk[:, None, None, None, :], scores, -1e9)
    p = _softmax(scores, axis=-1)
    out = torch.einsum("bhgqk,bhkd->bhgqd", p, v)
    return out.reshape(B, Hq, Sq, D)
```

```asm
; @launch grid=(256,1,1) block=(1024,1,1) lds=8448
.amdgcn_target "amdgcn-amd-amdhsa--gfx950"
.text
.globl standalone__paged_block_table_kv_pagedattention__decode_kernel
.p2align 8
.type standalone__paged_block_table_kv_pagedattention__decode_kernel,@function
standalone__paged_block_table_kv_pagedattention__decode_kernel:

    s_cmp_ge_u32 s2, 256
    s_cbranch_scc1 L_end
    s_load_dwordx16 s[4:19], s[0:1], 0
    s_memrealtime s[76:77]
    v_lshrrev_b32 v4, 6, v0
    v_and_b32 v1, 63, v0
    s_and_b32 s36, s2, 31
    v_readfirstlane_b32 s38, v4
    s_lshr_b32 s37, s2, 5
    v_lshrrev_b32 v13, 4, v1
    v_and_b32 v14, 15, v1
    s_and_b32 s3, s2, 7
    s_lshl_b32 s3, s3, 2
    s_lshr_b32 s3, 0x64320751, s3
    s_and_b32 s3, s3, 7
    s_and_b32 s36, s36, 24
    s_or_b32 s36, s36, s3
    s_lshl_b32 s3, s36, 8
    v_lshl_add_u32 v3, v14, 4, s3
    s_and_b32 s56, s38, 3
    s_lshl_b32 s58, s56, 2
    s_lshl_b32 s56, s56, 15
    v_lshl_add_u32 v2, v13, 13, v3
    v_add_u32 v2, s56, v2
    s_lshr_b32 s57, s38, 2
    s_lshl_b32 s57, s57, 3
    s_add_u32 s57, s57, s37
    s_lshl_b32 s60, s57, 4
    s_add_u32 s58, s58, s60
    s_lshl_b32 s57, s57, 2
    v_add_u32 v12, s58, v13
    s_mov_b32 s22, 34078720
    s_mov_b32 s23, 0x20000
    s_mov_b32 s26, 34078720
    s_mov_b32 s27, 0x20000
    s_mov_b32 s30, 8192
    s_mov_b32 s31, 0x20000
    s_waitcnt lgkmcnt(0)

    s_load_dword s39, s[12:13], 0
    s_load_dword s40, s[10:11], s57 offset:0
    s_load_dword s41, s[10:11], s57 offset:128
    s_load_dword s42, s[10:11], s57 offset:256
    s_load_dword s43, s[10:11], s57 offset:384
    s_load_dword s44, s[10:11], s57 offset:512
    s_load_dword s45, s[10:11], s57 offset:640
    s_load_dword s46, s[10:11], s57 offset:768
    s_load_dword s47, s[10:11], s57 offset:896

    s_mov_b32 s28, s4
    s_and_b32 s29, s5, 0xffff
    s_mov_b32 s20, s6
    s_and_b32 s21, s7, 0xffff
    s_mov_b32 s24, s8
    s_and_b32 s25, s9, 0xffff
    buffer_load_dwordx4 v[4:7], v3, s[28:31], 0 offen
    s_mov_b32 s68, s16
    s_and_b32 s69, s17, 0xffff
    s_mov_b32 s70, 256
    s_mov_b32 s71, 0x20000
    s_mov_b32 s32, s18
    s_and_b32 s33, s19, 0xffff
    s_mov_b32 s34, 524288
    s_mov_b32 s35, 0x20000
    s_mov_b32 s72, s14
    s_and_b32 s73, s15, 0xffff
    s_mov_b32 s74, 8192
    s_mov_b32 s75, 0x20000
    s_mul_i32 s60, s76, 0x9e3779b1
    s_add_u32 s77, s77, s60
    s_or_b32 s76, s76, 0x80000000
    s_or_b32 s77, s77, 0x80000000
    v_mov_b32 v104, s76
    v_writelane_b32 v104, s77, 1
    v_mov_b32 v105, 0
    v_lshl_add_u32 v106, v1, 3, 4
    s_lshl_b32 s60, s2, 4
    s_add_u32 s60, s60, s38
    s_cmp_lg_u32 s60, 1
    s_cbranch_scc1 L_noleader
    s_mov_b64 exec, 3
    buffer_atomic_cmpswap v[104:105], v106, s[68:71], 0 offen sc1
    s_mov_b64 exec, -1
L_noleader:
    s_waitcnt lgkmcnt(0)
    s_cmp_lt_i32 s39, 1
    s_cselect_b32 s59, 0, -1
    s_cselect_b32 s39, 4096, s39
    s_min_i32 s39, s39, 4096

    s_lshl_b32 s40, s40, 17
    s_sub_i32 s48, s39, 0
    s_cmp_lt_i32 s58, s48
    s_cselect_b32 s40, s40, 34078720
    buffer_load_dwordx4 v[16:19], v2, s[20:23], s40 offen nt
    s_lshl_b32 s41, s41, 17
    s_sub_i32 s49, s39, 512
    s_cmp_lt_i32 s58, s49
    s_cselect_b32 s41, s41, 34078720
    buffer_load_dwordx4 v[20:23], v2, s[20:23], s41 offen nt
    s_lshl_b32 s42, s42, 17
    s_sub_i32 s50, s39, 1024
    s_cmp_lt_i32 s58, s50
    s_cselect_b32 s42, s42, 34078720
    buffer_load_dwordx4 v[24:27], v2, s[20:23], s42 offen nt
    s_lshl_b32 s43, s43, 17
    s_sub_i32 s51, s39, 1536
    s_cmp_lt_i32 s58, s51
    s_cselect_b32 s43, s43, 34078720
    buffer_load_dwordx4 v[28:31], v2, s[20:23], s43 offen nt
    s_lshl_b32 s44, s44, 17
    s_sub_i32 s52, s39, 2048
    s_cmp_lt_i32 s58, s52
    s_cselect_b32 s44, s44, 34078720
    buffer_load_dwordx4 v[32:35], v2, s[20:23], s44 offen nt
    s_lshl_b32 s45, s45, 17
    s_sub_i32 s53, s39, 2560
    s_cmp_lt_i32 s58, s53
    s_cselect_b32 s45, s45, 34078720
    buffer_load_dwordx4 v[36:39], v2, s[20:23], s45 offen nt
    s_lshl_b32 s46, s46, 17
    s_sub_i32 s54, s39, 3072
    s_cmp_lt_i32 s58, s54
    s_cselect_b32 s46, s46, 34078720
    buffer_load_dwordx4 v[40:43], v2, s[20:23], s46 offen nt
    s_lshl_b32 s47, s47, 17
    s_sub_i32 s55, s39, 3584
    s_cmp_lt_i32 s58, s55
    s_cselect_b32 s47, s47, 34078720
    buffer_load_dwordx4 v[44:47], v2, s[20:23], s47 offen nt

    s_lshl_b32 s60, s38, 2
    v_mov_b32 v96, s60
    v_lshlrev_b32 v97, 2, v14
    v_lshlrev_b32 v99, 3, v1
    s_lshl_b32 s61, s38, 9
    v_add_u32 v100, s61, v99
    v_lshlrev_b32 v98, 4, v1
    s_lshl_b32 s65, s36, 14
    s_lshl_b32 s64, s37, 11
    s_add_u32 s64, s64, s65
    v_and_b32 v10, 7, v1
    v_lshlrev_b32 v10, 11, v10
    v_lshlrev_b32 v11, 4, v14
    v_lshl_add_u32 v11, v13, 2, v11
    s_lshl_b32 s67, s36, 8
    s_lshl_b32 s66, s36, 3
    v_mov_b32 v15, 0
    v_mov_b32 v103, 0xff800000
    v_mov_b32 v107, s66
    s_mov_b32 s79, 0xd0284a96

    v_mov_b32 v88, 0
    v_mov_b32 v89, 0
    v_mov_b32 v90, 0
    v_mov_b32 v91, 0
    v_mov_b32 v92, 0
    v_mov_b32 v93, 0
    v_mov_b32 v94, 0
    v_mov_b32 v95, 0
    s_waitcnt vmcnt(8)
    v_and_b32 v4, s59, v4
    v_and_b32 v5, s59, v5
    v_and_b32 v6, s59, v6
    v_and_b32 v7, s59, v7
    s_waitcnt vmcnt(7)
    buffer_load_dwordx4 v[48:51], v2, s[24:27], s40 offen nt
    v_dot2_f32_bf16 v80, v16, v4, 0
    v_dot2_f32_bf16 v80, v17, v5, v80
    v_dot2_f32_bf16 v80, v18, v6, v80
    v_dot2_f32_bf16 v80, v19, v7, v80
    s_waitcnt vmcnt(7)
    buffer_load_dwordx4 v[52:55], v2, s[24:27], s41 offen nt
    v_dot2_f32_bf16 v81, v20, v4, 0
    v_dot2_f32_bf16 v81, v21, v5, v81
    v_dot2_f32_bf16 v81, v22, v6, v81
    v_dot2_f32_bf16 v81, v23, v7, v81
    s_waitcnt vmcnt(7)
    buffer_load_dwordx4 v[56:59], v2, s[24:27], s42 offen nt
    v_dot2_f32_bf16 v82, v24, v4, 0
    v_dot2_f32_bf16 v82, v25, v5, v82
    v_dot2_f32_bf16 v82, v26, v6, v82
    v_dot2_f32_bf16 v82, v27, v7, v82
    s_waitcnt vmcnt(7)
    buffer_load_dwordx4 v[60:63], v2, s[24:27], s43 offen nt
    v_dot2_f32_bf16 v83, v28, v4, 0
    v_dot2_f32_bf16 v83, v29, v5, v83
    v_dot2_f32_bf16 v83, v30, v6, v83
    v_dot2_f32_bf16 v83, v31, v7, v83
    s_waitcnt vmcnt(7)
    buffer_load_dwordx4 v[64:67], v2, s[24:27], s44 offen nt
    v_dot2_f32_bf16 v84, v32, v4, 0
    v_dot2_f32_bf16 v84, v33, v5, v84
    v_dot2_f32_bf16 v84, v34, v6, v84
    v_dot2_f32_bf16 v84, v35, v7, v84
    s_waitcnt vmcnt(7)
    buffer_load_dwordx4 v[68:71], v2, s[24:27], s45 offen nt
    v_dot2_f32_bf16 v85, v36, v4, 0
    v_dot2_f32_bf16 v85, v37, v5, v85
    v_dot2_f32_bf16 v85, v38, v6, v85
    v_dot2_f32_bf16 v85, v39, v7, v85
    s_waitcnt vmcnt(7)
    buffer_load_dwordx4 v[72:75], v2, s[24:27], s46 offen nt
    v_dot2_f32_bf16 v86, v40, v4, 0
    v_dot2_f32_bf16 v86, v41, v5, v86
    v_dot2_f32_bf16 v86, v42, v6, v86
    v_dot2_f32_bf16 v86, v43, v7, v86
    s_waitcnt vmcnt(7)
    buffer_load_dwordx4 v[76:79], v2, s[24:27], s47 offen nt
    v_dot2_f32_bf16 v87, v44, v4, 0
    v_dot2_f32_bf16 v87, v45, v5, v87
    v_dot2_f32_bf16 v87, v46, v6, v87
    v_dot2_f32_bf16 v87, v47, v7, v87
    s_nop 3
    v_add_f32_dpp v80, v80, v80 row_ror:8 row_mask:0xf bank_mask:0xf
    v_add_f32_dpp v81, v81, v81 row_ror:8 row_mask:0xf bank_mask:0xf
    v_add_f32_dpp v82, v82, v82 row_ror:8 row_mask:0xf bank_mask:0xf
    v_add_f32_dpp v83, v83, v83 row_ror:8 row_mask:0xf bank_mask:0xf
    v_add_f32_dpp v84, v84, v84 row_ror:8 row_mask:0xf bank_mask:0xf
    v_add_f32_dpp v85, v85, v85 row_ror:8 row_mask:0xf bank_mask:0xf
    v_add_f32_dpp v86, v86, v86 row_ror:8 row_mask:0xf bank_mask:0xf
    v_add_f32_dpp v87, v87, v87 row_ror:8 row_mask:0xf bank_mask:0xf
    v_add_f32_dpp v80, v80, v80 row_ror:4 row_mask:0xf bank_mask:0xf
    v_add_f32_dpp v81, v81, v81 row_ror:4 row_mask:0xf bank_mask:0xf
    v_add_f32_dpp v82, v82, v82 row_ror:4 row_mask:0xf bank_mask:0xf
    v_add_f32_dpp v83, v83, v83 row_ror:4 row_mask:0xf bank_mask:0xf
    v_add_f32_dpp v84, v84, v84 row_ror:4 row_mask:0xf bank_mask:0xf
    v_add_f32_dpp v85, v85, v85 row_ror:4 row_mask:0xf bank_mask:0xf
    v_add_f32_dpp v86, v86, v86 row_ror:4 row_mask:0xf bank_mask:0xf
    v_add_f32_dpp v87, v87, v87 row_ror:4 row_mask:0xf bank_mask:0xf
    v_add_f32_dpp v80, v80, v80 row_ror:2 row_mask:0xf bank_mask:0xf
    v_add_f32_dpp v81, v81, v81 row_ror:2 row_mask:0xf bank_mask:0xf
    v_add_f32_dpp v82, v82, v82 row_ror:2 row_mask:0xf bank_mask:0xf
    v_add_f32_dpp v83, v83, v83 row_ror:2 row_mask:0xf bank_mask:0xf
    v_add_f32_dpp v84, v84, v84 row_ror:2 row_mask:0xf bank_mask:0xf
    v_add_f32_dpp v85, v85, v85 row_ror:2 row_mask:0xf bank_mask:0xf
    v_add_f32_dpp v86, v86, v86 row_ror:2 row_mask:0xf bank_mask:0xf
    v_add_f32_dpp v87, v87, v87 row_ror:2 row_mask:0xf bank_mask:0xf
    v_add_f32_dpp v80, v80, v80 row_ror:1 row_mask:0xf bank_mask:0xf
    v_add_f32_dpp v81, v81, v81 row_ror:1 row_mask:0xf bank_mask:0xf
    v_add_f32_dpp v82, v82, v82 row_ror:1 row_mask:0xf bank_mask:0xf
    v_add_f32_dpp v83, v83, v83 row_ror:1 row_mask:0xf bank_mask:0xf
    v_add_f32_dpp v84, v84, v84 row_ror:1 row_mask:0xf bank_mask:0xf
    v_add_f32_dpp v85, v85, v85 row_ror:1 row_mask:0xf bank_mask:0xf
    v_add_f32_dpp v86, v86, v86 row_ror:1 row_mask:0xf bank_mask:0xf
    v_add_f32_dpp v87, v87, v87 row_ror:1 row_mask:0xf bank_mask:0xf
    v_cmp_gt_i32 s[4:5], s48, v12
    v_cmp_gt_i32 s[6:7], s49, v12
    v_cmp_gt_i32 s[8:9], s50, v12
    v_cmp_gt_i32 s[10:11], s51, v12
    v_cndmask_b32 v80, v103, v80, s[4:5]
    v_cndmask_b32 v81, v103, v81, s[6:7]
    v_cndmask_b32 v82, v103, v82, s[8:9]
    v_cndmask_b32 v83, v103, v83, s[10:11]
    v_cmp_gt_i32 s[4:5], s52, v12
    v_cmp_gt_i32 s[6:7], s53, v12
    v_cmp_gt_i32 s[8:9], s54, v12
    v_cmp_gt_i32 s[10:11], s55, v12
    v_max3_f32 v101, v80, v81, v82
    v_cndmask_b32 v84, v103, v84, s[4:5]
    v_cndmask_b32 v85, v103, v85, s[6:7]
    v_cndmask_b32 v86, v103, v86, s[8:9]
    v_cndmask_b32 v87, v103, v87, s[10:11]
    v_max3_f32 v102, v83, v84, v85
    v_max3_f32 v101, v101, v86, v87
    v_max_f32 v101, v101, v102
    v_max_f32 v101, 0xff7fffff, v101
    s_mov_b32 s62, 1040356334
    v_mov_b32 v102, v101
    s_nop 1
    v_permlane16_swap_b32 v101, v102
    s_nop 1
    v_max_f32 v101, v101, v102
    v_mov_b32 v102, v101
    s_nop 1
    v_permlane32_swap_b32 v101, v102
    s_nop 1
    v_max_f32 v101, v101, v102
    v_sub_f32 v80, v80, v101
    v_sub_f32 v81, v81, v101
    v_sub_f32 v82, v82, v101
    v_sub_f32 v83, v83, v101
    v_sub_f32 v84, v84, v101
    v_sub_f32 v85, v85, v101
    v_sub_f32 v86, v86, v101
    v_sub_f32 v87, v87, v101
    v_mul_f32 v80, s62, v80
    v_mul_f32 v81, s62, v81
    v_mul_f32 v82, s62, v82
    v_mul_f32 v83, s62, v83
    v_mul_f32 v84, s62, v84
    v_mul_f32 v85, s62, v85
    v_mul_f32 v86, s62, v86
    v_mul_f32 v87, s62, v87
    v_exp_f32 v80, v80
    v_exp_f32 v81, v81
    v_exp_f32 v82, v82
    v_exp_f32 v83, v83
    v_exp_f32 v84, v84
    v_exp_f32 v85, v85
    v_exp_f32 v86, v86
    v_exp_f32 v87, v87
    ds_write_b32 v96, v101 offset:8192
    v_add_f32 v16, v80, v81
    v_add_f32 v17, v82, v83
    v_add_f32 v18, v84, v85
    v_add_f32 v19, v86, v87
    v_add_f32 v16, v16, v17
    v_add_f32 v18, v18, v19
    v_add_f32 v16, v16, v18
    v_mov_b32 v17, v16
    s_nop 1
    v_permlane16_swap_b32 v16, v17
    s_nop 1
    v_add_f32 v16, v16, v17
    v_mov_b32 v17, v16
    s_nop 1
    v_permlane32_swap_b32 v16, v17
    s_nop 1
    v_add_f32 v16, v16, v17
    ds_write_b32 v96, v16 offset:8256
    s_waitcnt vmcnt(7)
    v_lshlrev_b32 v24, 16, v48
    v_and_b32 v25, 0xffff0000, v48
    v_lshlrev_b32 v26, 16, v49
    v_and_b32 v27, 0xffff0000, v49
    v_lshlrev_b32 v28, 16, v50
    v_and_b32 v29, 0xffff0000, v50
    v_lshlrev_b32 v30, 16, v51
    v_and_b32 v31, 0xffff0000, v51
    v_fmac_f32 v88, v80, v24
    v_fmac_f32 v89, v80, v25
    v_fmac_f32 v90, v80, v26
    v_fmac_f32 v91, v80, v27
    v_fmac_f32 v92, v80, v28
    v_fmac_f32 v93, v80, v29
    v_fmac_f32 v94, v80, v30
    v_fmac_f32 v95, v80, v31
    s_waitcnt vmcnt(6)
    v_lshlrev_b32 v24, 16, v52
    v_and_b32 v25, 0xffff0000, v52
    v_lshlrev_b32 v26, 16, v53
    v_and_b32 v27, 0xffff0000, v53
    v_lshlrev_b32 v28, 16, v54
    v_and_b32 v29, 0xffff0000, v54
    v_lshlrev_b32 v30, 16, v55
    v_and_b32 v31, 0xffff0000, v55
    v_fmac_f32 v88, v81, v24
    v_fmac_f32 v89, v81, v25
    v_fmac_f32 v90, v81, v26
    v_fmac_f32 v91, v81, v27
    v_fmac_f32 v92, v81, v28
    v_fmac_f32 v93, v81, v29
    v_fmac_f32 v94, v81, v30
    v_fmac_f32 v95, v81, v31
    s_waitcnt vmcnt(5)
    v_lshlrev_b32 v24, 16, v56
    v_and_b32 v25, 0xffff0000, v56
    v_lshlrev_b32 v26, 16, v57
    v_and_b32 v27, 0xffff0000, v57
    v_lshlrev_b32 v28, 16, v58
    v_and_b32 v29, 0xffff0000, v58
    v_lshlrev_b32 v30, 16, v59
    v_and_b32 v31, 0xffff0000, v59
    v_fmac_f32 v88, v82, v24
    v_fmac_f32 v89, v82, v25
    v_fmac_f32 v90, v82, v26
    v_fmac_f32 v91, v82, v27
    v_fmac_f32 v92, v82, v28
    v_fmac_f32 v93, v82, v29
    v_fmac_f32 v94, v82, v30
    v_fmac_f32 v95, v82, v31
    s_waitcnt vmcnt(4)
    v_lshlrev_b32 v24, 16, v60
    v_and_b32 v25, 0xffff0000, v60
    v_lshlrev_b32 v26, 16, v61
    v_and_b32 v27, 0xffff0000, v61
    v_lshlrev_b32 v28, 16, v62
    v_and_b32 v29, 0xffff0000, v62
    v_lshlrev_b32 v30, 16, v63
    v_and_b32 v31, 0xffff0000, v63
    v_fmac_f32 v88, v83, v24
    v_fmac_f32 v89, v83, v25
    v_fmac_f32 v90, v83, v26
    v_fmac_f32 v91, v83, v27
    v_fmac_f32 v92, v83, v28
    v_fmac_f32 v93, v83, v29
    v_fmac_f32 v94, v83, v30
    v_fmac_f32 v95, v83, v31
    s_waitcnt vmcnt(3)
    v_lshlrev_b32 v24, 16, v64
    v_and_b32 v25, 0xffff0000, v64
    v_lshlrev_b32 v26, 16, v65
    v_and_b32 v27, 0xffff0000, v65
    v_lshlrev_b32 v28, 16, v66
    v_and_b32 v29, 0xffff0000, v66
    v_lshlrev_b32 v30, 16, v67
    v_and_b32 v31, 0xffff0000, v67
    v_fmac_f32 v88, v84, v24
    v_fmac_f32 v89, v84, v25
    v_fmac_f32 v90, v84, v26
    v_fmac_f32 v91, v84, v27
    v_fmac_f32 v92, v84, v28
    v_fmac_f32 v93, v84, v29
    v_fmac_f32 v94, v84, v30
    v_fmac_f32 v95, v84, v31
    s_waitcnt vmcnt(2)
    v_lshlrev_b32 v24, 16, v68
    v_and_b32 v25, 0xffff0000, v68
    v_lshlrev_b32 v26, 16, v69
    v_and_b32 v27, 0xffff0000, v69
    v_lshlrev_b32 v28, 16, v70
    v_and_b32 v29, 0xffff0000, v70
    v_lshlrev_b32 v30, 16, v71
    v_and_b32 v31, 0xffff0000, v71
    v_fmac_f32 v88, v85, v24
    v_fmac_f32 v89, v85, v25
    v_fmac_f32 v90, v85, v26
    v_fmac_f32 v91, v85, v27
    v_fmac_f32 v92, v85, v28
    v_fmac_f32 v93, v85, v29
    v_fmac_f32 v94, v85, v30
    v_fmac_f32 v95, v85, v31
    s_waitcnt vmcnt(1)
    v_lshlrev_b32 v24, 16, v72
    v_and_b32 v25, 0xffff0000, v72
    v_lshlrev_b32 v26, 16, v73
    v_and_b32 v27, 0xffff0000, v73
    v_lshlrev_b32 v28, 16, v74
    v_and_b32 v29, 0xffff0000, v74
    v_lshlrev_b32 v30, 16, v75
    v_and_b32 v31, 0xffff0000, v75
    v_fmac_f32 v88, v86, v24
    v_fmac_f32 v89, v86, v25
    v_fmac_f32 v90, v86, v26
    v_fmac_f32 v91, v86, v27
    v_fmac_f32 v92, v86, v28
    v_fmac_f32 v93, v86, v29
    v_fmac_f32 v94, v86, v30
    v_fmac_f32 v95, v86, v31
    s_waitcnt vmcnt(0)
    v_lshlrev_b32 v24, 16, v76
    v_and_b32 v25, 0xffff0000, v76
    v_lshlrev_b32 v26, 16, v77
    v_and_b32 v27, 0xffff0000, v77
    v_lshlrev_b32 v28, 16, v78
    v_and_b32 v29, 0xffff0000, v78
    v_lshlrev_b32 v30, 16, v79
    v_and_b32 v31, 0xffff0000, v79
    v_fmac_f32 v88, v87, v24
    v_fmac_f32 v89, v87, v25
    v_fmac_f32 v90, v87, v26
    v_fmac_f32 v91, v87, v27
    v_fmac_f32 v92, v87, v28
    v_fmac_f32 v93, v87, v29
    v_fmac_f32 v94, v87, v30
    v_fmac_f32 v95, v87, v31
    s_nop 1
    v_permlane32_swap_b32 v88, v92
    v_permlane32_swap_b32 v89, v93
    v_permlane32_swap_b32 v90, v94
    v_permlane32_swap_b32 v91, v95
    s_nop 1
    v_add_f32 v88, v88, v92
    v_add_f32 v89, v89, v93
    v_add_f32 v90, v90, v94
    v_add_f32 v91, v91, v95
    s_nop 1
    v_permlane16_swap_b32 v88, v90
    v_permlane16_swap_b32 v89, v91
    s_nop 1
    v_add_f32 v88, v88, v90
    v_add_f32 v89, v89, v91
    ds_write_b64 v100, v[88:89]
    s_mov_b32 s78, 0
    s_cmp_lg_u32 s38, 0
    s_cbranch_scc1 L_bar
L_nonce:
    buffer_load_dwordx4 v[16:19], v15, s[68:71], 0 offen sc1
    s_waitcnt vmcnt(0)
    v_readfirstlane_b32 s76, v17
    v_readfirstlane_b32 s77, v19
    s_min_u32 s60, s76, s77
    s_cmp_lg_u32 s60, 0
    s_cbranch_scc1 L_bar
    s_add_u32 s78, s78, 1
    s_cmp_lg_u32 s78, 64
    s_cbranch_scc1 L_nonce_wait
    s_mov_b64 exec, 3
    buffer_atomic_cmpswap v[104:105], v106, s[68:71], 0 offen sc1
    s_mov_b64 exec, -1
    s_waitcnt vmcnt(0)
L_nonce_wait:
    s_sleep 8
    s_branch L_nonce
L_bar:
    s_waitcnt lgkmcnt(0)
    s_barrier
    s_cmp_lg_u32 s38, 0
    s_cbranch_scc1 L_fin
    v_mov_b32 v108, 1
    s_mov_b64 exec, 1
    buffer_atomic_add v108, v107, s[68:71], 0 offen sc0 sc1
    s_mov_b64 exec, -1
    ds_read_b32 v101, v97 offset:8192
    ds_read_b32 v34, v97 offset:8256

    ds_read_b64 v[48:49], v99 offset:0
    ds_read_b64 v[50:51], v99 offset:512
    ds_read_b64 v[52:53], v99 offset:1024
    ds_read_b64 v[54:55], v99 offset:1536
    ds_read_b64 v[56:57], v99 offset:2048
    ds_read_b64 v[58:59], v99 offset:2560
    ds_read_b64 v[60:61], v99 offset:3072
    ds_read_b64 v[62:63], v99 offset:3584
    ds_read_b64 v[64:65], v99 offset:4096
    ds_read_b64 v[66:67], v99 offset:4608
    ds_read_b64 v[68:69], v99 offset:5120
    ds_read_b64 v[70:71], v99 offset:5632
    ds_read_b64 v[72:73], v99 offset:6144
    ds_read_b64 v[74:75], v99 offset:6656
    ds_read_b64 v[76:77], v99 offset:7168
    ds_read_b64 v[78:79], v99 offset:7680
    v_mov_b32 v5, s76
    v_mov_b32 v7, s77
    v_mov_b32 v33, s76
    v_mov_b32 v35, s77
    s_waitcnt lgkmcnt(15)
    v_mov_b32 v32, v101
    s_nop 1
    v_max_f32_dpp v32, v32, v32 row_ror:8 row_mask:0xf bank_mask:0xf
    s_nop 1
    v_max_f32_dpp v32, v32, v32 row_ror:4 row_mask:0xf bank_mask:0xf
    s_nop 1
    v_max_f32_dpp v32, v32, v32 row_ror:2 row_mask:0xf bank_mask:0xf
    s_nop 1
    v_max_f32_dpp v32, v32, v32 row_ror:1 row_mask:0xf bank_mask:0xf
    v_sub_f32 v101, v101, v32
    v_mul_f32 v101, s62, v101
    v_exp_f32 v101, v101
    v_mov_b32 v4, 0
    v_mov_b32 v6, 0
    v_mov_b32 v8, 0
    v_mov_b32 v9, 0
    v_mul_f32 v34, v34, v101
    s_waitcnt lgkmcnt(12)
    v_fmac_f32_dpp v4, v101, v48 row_newbcast:0 row_mask:0xf bank_mask:0xf
    v_fmac_f32_dpp v6, v101, v49 row_newbcast:0 row_mask:0xf bank_mask:0xf
    v_fmac_f32_dpp v8, v101, v50 row_newbcast:1 row_mask:0xf bank_mask:0xf
    v_fmac_f32_dpp v9, v101, v51 row_newbcast:1 row_mask:0xf bank_mask:0xf
    v_add_f32_dpp v34, v34, v34 row_ror:8 row_mask:0xf bank_mask:0xf
    v_fmac_f32_dpp v4, v101, v52 row_newbcast:2 row_mask:0xf bank_mask:0xf
    v_fmac_f32_dpp v6, v101, v53 row_newbcast:2 row_mask:0xf bank_mask:0xf
    v_fmac_f32_dpp v8, v101, v54 row_newbcast:3 row_mask:0xf bank_mask:0xf
    v_fmac_f32_dpp v9, v101, v55 row_newbcast:3 row_mask:0xf bank_mask:0xf
    s_waitcnt lgkmcnt(8)
    v_fmac_f32_dpp v4, v101, v56 row_newbcast:4 row_mask:0xf bank_mask:0xf
    v_fmac_f32_dpp v6, v101, v57 row_newbcast:4 row_mask:0xf bank_mask:0xf
    v_fmac_f32_dpp v8, v101, v58 row_newbcast:5 row_mask:0xf bank_mask:0xf
    v_fmac_f32_dpp v9, v101, v59 row_newbcast:5 row_mask:0xf bank_mask:0xf
    v_add_f32_dpp v34, v34, v34 row_ror:4 row_mask:0xf bank_mask:0xf
    v_fmac_f32_dpp v4, v101, v60 row_newbcast:6 row_mask:0xf bank_mask:0xf
    v_fmac_f32_dpp v6, v101, v61 row_newbcast:6 row_mask:0xf bank_mask:0xf
    v_fmac_f32_dpp v8, v101, v62 row_newbcast:7 row_mask:0xf bank_mask:0xf
    v_fmac_f32_dpp v9, v101, v63 row_newbcast:7 row_mask:0xf bank_mask:0xf
    s_waitcnt lgkmcnt(4)
    v_fmac_f32_dpp v4, v101, v64 row_newbcast:8 row_mask:0xf bank_mask:0xf
    v_fmac_f32_dpp v6, v101, v65 row_newbcast:8 row_mask:0xf bank_mask:0xf
    v_fmac_f32_dpp v8, v101, v66 row_newbcast:9 row_mask:0xf bank_mask:0xf
    v_fmac_f32_dpp v9, v101, v67 row_newbcast:9 row_mask:0xf bank_mask:0xf
    v_add_f32_dpp v34, v34, v34 row_ror:2 row_mask:0xf bank_mask:0xf
    v_fmac_f32_dpp v4, v101, v68 row_newbcast:10 row_mask:0xf bank_mask:0xf
    v_fmac_f32_dpp v6, v101, v69 row_newbcast:10 row_mask:0xf bank_mask:0xf
    v_fmac_f32_dpp v8, v101, v70 row_newbcast:11 row_mask:0xf bank_mask:0xf
    v_fmac_f32_dpp v9, v101, v71 row_newbcast:11 row_mask:0xf bank_mask:0xf
    s_waitcnt lgkmcnt(0)
    v_fmac_f32_dpp v4, v101, v72 row_newbcast:12 row_mask:0xf bank_mask:0xf
    v_fmac_f32_dpp v6, v101, v73 row_newbcast:12 row_mask:0xf bank_mask:0xf
    v_fmac_f32_dpp v8, v101, v74 row_newbcast:13 row_mask:0xf bank_mask:0xf
    v_fmac_f32_dpp v9, v101, v75 row_newbcast:13 row_mask:0xf bank_mask:0xf
    v_add_f32_dpp v34, v34, v34 row_ror:1 row_mask:0xf bank_mask:0xf
    v_fmac_f32_dpp v4, v101, v76 row_newbcast:14 row_mask:0xf bank_mask:0xf
    v_fmac_f32_dpp v6, v101, v77 row_newbcast:14 row_mask:0xf bank_mask:0xf
    v_fmac_f32_dpp v8, v101, v78 row_newbcast:15 row_mask:0xf bank_mask:0xf
    v_fmac_f32_dpp v9, v101, v79 row_newbcast:15 row_mask:0xf bank_mask:0xf
    v_add_f32 v4, v4, v8
    v_add_f32 v6, v6, v9
    buffer_store_dwordx4 v[4:7], v98, s[32:35], s64 offen sc1
    s_mov_b64 exec, 1
    buffer_store_dwordx4 v[32:35], v15, s[32:35], s64 offen offset:1024 sc1
    s_mov_b64 exec, -1
    s_lshl_b32 s60, 0x01010101, s37
    s_not_b32 s60, s60
    s_mov_b32 s61, s60
    s_add_u32 s40, s65, 4096
    s_add_u32 s41, s65, 8192
    s_add_u32 s42, s65, 12288
    v_mov_b32 v36, v32
    v_mov_b32 v37, v33
    v_mov_b32 v38, v34
    v_mov_b32 v39, v35
    v_mov_b32 v48, v4
    v_mov_b32 v49, v5
    v_mov_b32 v50, v6
    v_mov_b32 v51, v7
    v_mov_b32 v52, v4
    v_mov_b32 v53, v5
    v_mov_b32 v54, v6
    v_mov_b32 v55, v7
    v_mov_b32 v56, v4
    v_mov_b32 v57, v5
    v_mov_b32 v58, v6
    v_mov_b32 v59, v7
    v_mov_b32 v60, v4
    v_mov_b32 v61, v5
    v_mov_b32 v62, v6
    v_mov_b32 v63, v7
    v_mov_b32 v64, v4
    v_mov_b32 v65, v5
    v_mov_b32 v66, v6
    v_mov_b32 v67, v7
    v_mov_b32 v68, v4
    v_mov_b32 v69, v5
    v_mov_b32 v70, v6
    v_mov_b32 v71, v7
    v_mov_b32 v72, v4
    v_mov_b32 v73, v5
    v_mov_b32 v74, v6
    v_mov_b32 v75, v7
    v_mov_b32 v76, v4
    v_mov_b32 v77, v5
    v_mov_b32 v78, v6
    v_mov_b32 v79, v7
    s_waitcnt vmcnt(2)
    v_readfirstlane_b32 s3, v108
    s_cmp_lg_u32 s3, 7
    s_cbranch_scc1 L_fin
L_fetch:
    s_mov_b64 exec, s[60:61]
    buffer_load_dwordx4 v[36:39], v10, s[32:35], s65 offen offset:1024 sc1
    s_mov_b64 exec, -1
    s_cmp_eq_u32 s37, 0
    s_cbranch_scc1 L_own0
    buffer_load_dwordx4 v[48:51], v98, s[32:35], s65 offen offset:0 sc1
L_own0:
    s_cmp_eq_u32 s37, 1
    s_cbranch_scc1 L_own1
    buffer_load_dwordx4 v[52:55], v98, s[32:35], s65 offen offset:2048 sc1
L_own1:
    s_cmp_eq_u32 s37, 2
    s_cbranch_scc1 L_own2
    buffer_load_dwordx4 v[56:59], v98, s[32:35], s40 offen offset:0 sc1
L_own2:
    s_cmp_eq_u32 s37, 3
    s_cbranch_scc1 L_own3
    buffer_load_dwordx4 v[60:63], v98, s[32:35], s40 offen offset:2048 sc1
L_own3:
    s_cmp_eq_u32 s37, 4
    s_cbranch_scc1 L_own4
    buffer_load_dwordx4 v[64:67], v98, s[32:35], s41 offen offset:0 sc1
L_own4:
    s_cmp_eq_u32 s37, 5
    s_cbranch_scc1 L_own5
    buffer_load_dwordx4 v[68:71], v98, s[32:35], s41 offen offset:2048 sc1
L_own5:
    s_cmp_eq_u32 s37, 6
    s_cbranch_scc1 L_own6
    buffer_load_dwordx4 v[72:75], v98, s[32:35], s42 offen offset:0 sc1
L_own6:
    s_cmp_eq_u32 s37, 7
    s_cbranch_scc1 L_own7
    buffer_load_dwordx4 v[76:79], v98, s[32:35], s42 offen offset:2048 sc1
L_own7:
    s_waitcnt vmcnt(7)
    v_xor_b32 v43, s76, v37
    v_xor_b32 v44, s77, v39
    v_mov_b32 v40, v36
    s_nop 1
    v_max_f32_dpp v40, v40, v40 row_ror:4 row_mask:0xf bank_mask:0xf
    s_nop 1
    v_max_f32_dpp v40, v40, v40 row_ror:2 row_mask:0xf bank_mask:0xf
    s_nop 1
    v_max_f32_dpp v40, v40, v40 row_ror:1 row_mask:0xf bank_mask:0xf
    v_sub_f32 v41, v36, v40
    v_mul_f32 v41, s62, v41
    v_exp_f32 v41, v41
    v_or_b32 v43, v43, v44
    v_mul_f32 v42, v38, v41
    s_nop 1
    v_add_f32_dpp v42, v42, v42 quad_perm:[1,0,3,2] row_mask:0xf bank_mask:0xf
    s_nop 1
    v_add_f32_dpp v42, v42, v42 quad_perm:[2,3,0,1] row_mask:0xf bank_mask:0xf
    s_nop 1
    v_add_f32_dpp v42, v42, v42 row_ror:4 row_mask:0xf bank_mask:0xf
    v_rcp_f32 v45, v42
    v_mov_b32 v8, 0
    v_mov_b32 v9, 0
    v_cmp_gt_f32 s[6:7], s79, v40
    s_waitcnt vmcnt(6)
    v_xor_b32 v46, s76, v49
    v_xor_b32 v47, s77, v51
    v_fmac_f32_dpp v8, v41, v48 row_newbcast:0 row_mask:0xf bank_mask:0xf
    v_fmac_f32_dpp v9, v41, v50 row_newbcast:0 row_mask:0xf bank_mask:0xf
    v_or3_b32 v43, v43, v46, v47
    s_waitcnt vmcnt(5)
    v_xor_b32 v46, s76, v53
    v_xor_b32 v47, s77, v55
    v_fmac_f32_dpp v8, v41, v52 row_newbcast:1 row_mask:0xf bank_mask:0xf
    v_fmac_f32_dpp v9, v41, v54 row_newbcast:1 row_mask:0xf bank_mask:0xf
    v_or3_b32 v43, v43, v46, v47
    s_waitcnt vmcnt(4)
    v_xor_b32 v46, s76, v57
    v_xor_b32 v47, s77, v59
    v_fmac_f32_dpp v8, v41, v56 row_newbcast:2 row_mask:0xf bank_mask:0xf
    v_fmac_f32_dpp v9, v41, v58 row_newbcast:2 row_mask:0xf bank_mask:0xf
    v_or3_b32 v43, v43, v46, v47
    s_waitcnt vmcnt(3)
    v_xor_b32 v46, s76, v61
    v_xor_b32 v47, s77, v63
    v_fmac_f32_dpp v8, v41, v60 row_newbcast:3 row_mask:0xf bank_mask:0xf
    v_fmac_f32_dpp v9, v41, v62 row_newbcast:3 row_mask:0xf bank_mask:0xf
    v_or3_b32 v43, v43, v46, v47
    s_waitcnt vmcnt(2)
    v_xor_b32 v46, s76, v65
    v_xor_b32 v47, s77, v67
    v_fmac_f32_dpp v8, v41, v64 row_newbcast:4 row_mask:0xf bank_mask:0xf
    v_fmac_f32_dpp v9, v41, v66 row_newbcast:4 row_mask:0xf bank_mask:0xf
    v_or3_b32 v43, v43, v46, v47
    s_waitcnt vmcnt(1)
    v_xor_b32 v46, s76, v69
    v_xor_b32 v47, s77, v71
    v_fmac_f32_dpp v8, v41, v68 row_newbcast:5 row_mask:0xf bank_mask:0xf
    v_fmac_f32_dpp v9, v41, v70 row_newbcast:5 row_mask:0xf bank_mask:0xf
    v_or3_b32 v43, v43, v46, v47
    s_waitcnt vmcnt(0)
    v_xor_b32 v46, s76, v73
    v_xor_b32 v47, s77, v75
    v_fmac_f32_dpp v8, v41, v72 row_newbcast:6 row_mask:0xf bank_mask:0xf
    v_fmac_f32_dpp v9, v41, v74 row_newbcast:6 row_mask:0xf bank_mask:0xf
    v_or3_b32 v43, v43, v46, v47
    s_waitcnt vmcnt(0)
    v_xor_b32 v46, s76, v77
    v_xor_b32 v47, s77, v79
    v_fmac_f32_dpp v8, v41, v76 row_newbcast:7 row_mask:0xf bank_mask:0xf
    v_fmac_f32_dpp v9, v41, v78 row_newbcast:7 row_mask:0xf bank_mask:0xf
    v_or3_b32 v43, v43, v46, v47
    v_cmp_ne_u32 vcc, 0, v43
    s_or_b64 s[4:5], vcc, s[6:7]
    s_cbranch_scc1 L_rare
L_valid:
    v_mul_f32 v8, v8, v45
    v_mul_f32 v9, v9, v45
    v_cvt_pk_bf16_f32 v8, v8, v9
    buffer_store_dword v8, v11, s[72:75], s67 offen
    s_branch L_fin
L_rare:
    s_cbranch_vccz L_masked
    s_add_u32 s78, s78, 1
    s_cmp_lt_u32 s78, 0x100000
    s_cbranch_scc1 L_fetch
    s_branch L_valid
L_masked:
    s_cmp_ge_u32 s39, 4096
    s_cbranch_scc1 L_valid
    s_load_dwordx2 s[10:11], s[0:1], 24
    v_mov_b32 v46, 0xd0284a9a
    v_max_f32 v47, v40, v46
    v_sub_f32 v40, v40, v47
    v_sub_f32 v46, v46, v47
    v_mul_f32 v40, s62, v40
    v_mul_f32 v46, s62, v46
    v_exp_f32 v40, v40
    v_exp_f32 v46, v46
    s_sub_u32 s60, 4096, s39
    v_cvt_f32_u32 v43, s60
    v_mul_f32 v8, v8, v40
    v_mul_f32 v9, v9, v40
    v_mul_f32 v42, v42, v40
    v_fmac_f32 v42, v43, v46
    v_rcp_f32 v45, v42
    v_add_u32 v44, s67, v11
    v_mov_b32 v48, 0
    v_mov_b32 v49, 0
    s_mov_b32 s60, s39
    s_waitcnt lgkmcnt(0)
L_mloop:
    s_cmp_ge_u32 s60, 4096
    s_cbranch_scc1 L_mdone
    s_lshr_b32 s61, s60, 4
    s_lshl_b32 s61, s61, 2
    s_load_dword s62, s[10:11], s61
    s_and_b32 s63, s60, 15
    s_lshl_b32 s63, s63, 13
    s_waitcnt lgkmcnt(0)
    s_lshl_b32 s62, s62, 17
    s_add_u32 s62, s62, s63
    buffer_load_dword v50, v44, s[24:27], s62 offen
    s_add_u32 s60, s60, 1
    s_waitcnt vmcnt(0)
    v_lshlrev_b32 v51, 16, v50
    v_and_b32 v52, 0xffff0000, v50
    v_add_f32 v48, v48, v51
    v_add_f32 v49, v49, v52
    s_branch L_mloop
L_mdone:
    v_fmac_f32 v8, v48, v46
    v_fmac_f32 v9, v49, v46
    s_branch L_valid
L_fin:
L_end:
    s_endpgm
.section .rodata,"a"
.p2align 6
.amdhsa_kernel standalone__paged_block_table_kv_pagedattention__decode_kernel
  .amdhsa_next_free_vgpr 112
  .amdhsa_next_free_sgpr 96
  .amdhsa_accum_offset 112
  .amdhsa_group_segment_fixed_size 0
  .amdhsa_kernarg_size 64
  .amdhsa_user_sgpr_count 2
  .amdhsa_user_sgpr_kernarg_segment_ptr 1
  .amdhsa_system_sgpr_workgroup_id_x 1
.end_amdhsa_kernel
```
